```python
import torch

def _softmax(x, axis=-1):
    return torch.softmax(x, dim=axis)
def _gelu(x):
    return torch.nn.functional.gelu(x, approximate="tanh")
def _silu(x):
    return torch.nn.functional.silu(x)
def _sigmoid(x):
    return torch.sigmoid(x)
def _layernorm(x, axis=-1, eps=1e-5):
    m = x.mean(dim=axis, keepdim=True)
    v = x.var(dim=axis, keepdim=True, unbiased=False)
    return (x - m) / torch.sqrt(v + eps)
def _scatter_add(tgt, idx, src, axis=0):
    return tgt.clone().index_add_(axis, idx, src)
def _segment_sum(src, seg, n):
    out = torch.zeros((n,) + src.shape[1:], dtype=src.dtype)
    return out.index_add_(0, seg, src)
def _pad(x, pw):
    flat = tuple(v for pair in reversed(pw) for v in pair)
    return torch.nn.functional.pad(x, flat)

kernel_name = 'standalone__depthwise_separable__vision'

def setup_inputs():

    _w = (lambda a: (lambda t: t.to(torch.bfloat16) if t.is_floating_point() else t)(torch.as_tensor(a)))
    H = W = 512
    C = 96
    k = 1
    return {
        "x": _w((lambda *s: torch.randn(*s, dtype=torch.bfloat16) * 0.05)(1, H, W, C)),
        "dw": _w((lambda *s: torch.randn(*s, dtype=torch.bfloat16) * 0.05)(k, k, C)),
        "pw": _w((lambda *s: torch.randn(*s, dtype=torch.bfloat16) * 0.05)(C, C)),
    }

def reference(x, dw, pw):
    B, H, W, C = x.shape
    k = dw.shape[0]
    pad = k // 2
    xp = _pad(x, ((0,0),(pad,pad),(pad,pad),(0,0)))
    out = torch.zeros_like(x)
    for i in range(k):
        for j in range(k):
            out = out + xp[:, i:i+H, j:j+W, :] * dw[i, j][None, None, None, :]
    return torch.einsum('bhwc,cd->bhwd', out, pw)
```

```asm
; @launch grid=(256,1,1) block=(384,1,1) lds=84000
.amdgcn_target "amdgcn-amd-amdhsa--gfx950"
.text
.globl standalone__depthwise_separable__vision_kernel
.p2align 12
.p2align 8
.type standalone__depthwise_separable__vision_kernel,@function
standalone__depthwise_separable__vision_kernel:
    s_load_dwordx2 s[12:13], s[0:1], 0
    s_load_dwordx2 s[20:21], s[0:1], 16
    s_load_dwordx2 s[24:25], s[0:1], 8
    s_load_dwordx2 s[16:17], s[0:1], 24
    s_load_dwordx2 s[36:37], s[0:1], 32
    s_cmp_ge_u32 s2, 256
    s_cbranch_scc1 L_end
    v_lshrrev_b32 v7, 6, v0
    v_and_b32 v0, 63, v0
    v_readfirstlane_b32 s3, v7
    s_lshr_b32 s32, s2, 3
    s_lshl_b32 s32, s32, 2
    s_and_b32 s33, s2, 3
    s_or_b32 s38, s32, s33
    s_bfe_u32 s39, s2, 0x10002
    s_mul_i32 s55, s38, 49152
    s_cmp_lg_u32 s3, 5
    s_cbranch_scc1 L_worker
    s_setprio 3
    v_mov_b32 v1, 60416
    v_mov_b32 v2, 0
    v_mov_b32 v3, 10
    ds_write_b64 v1, v[2:3]
    s_cmp_lt_u32 s55, 2072576
    s_cselect_b32 s44, 32, 0
    s_or_b32 s44, s44, 31
    s_mov_b64 s[52:53], -1
    s_getreg_b32 s54, hwreg(HW_REG_XCC_ID, 0, 3)
    s_lshl_b32 s32, s39, 11
    s_and_b32 s56, s2, 8
    s_mul_i32 s33, s56, 3145728
    s_add_u32 s55, s55, s33
    s_add_u32 s55, s55, 18890752
    s_mul_i32 s56, s56, 16
    s_sub_u32 s50, s54, s2
    s_mov_b32 s51, 0
    s_mov_b32 s42, 8
    s_cmp_ge_u32 s2, 32
    s_waitcnt lgkmcnt(0)
    s_cbranch_scc1 L_voted
    s_add_u32 s48, s55, s12
    s_and_b32 s48, s48, 0xffffc000
    s_lshr_b32 s33, s48, 8
    s_and_b32 s33, s33, 0x2000
    s_or_b32 s48, s48, s33
    s_or_b32 s48, s48, s32
    s_xor_b32 s49, s48, 0x2040
    s_sub_u32 s48, s48, s12
    s_sub_u32 s49, s49, s12
    s_and_b32 s54, s54, 4
    s_add_u32 s50, s50, s54
    s_load_dword s52, s[12:13], s48 glc
    s_load_dword s53, s[12:13], s49 glc
    s_barrier
    s_waitcnt lgkmcnt(1)
    s_cmp_eq_u32 s52, -1
    s_cselect_b32 s32, 4, 0
    s_add_u32 s50, s50, s32
    s_or_b32 s50, s50, 8
    s_atomic_cmpswap s[50:51], s[36:37], s56
    s_branch L_voted2
L_voted:
    s_barrier
L_voted2:
    s_barrier
    s_sleep 5
    s_load_dword s58, s[36:37], 0
    s_load_dword s59, s[36:37], 128
L_chk:
    s_waitcnt lgkmcnt(0)
    s_min_u32 s32, s58, s59
    s_cmp_lg_u32 s32, 0
    s_cbranch_scc1 L_full
    s_sub_u32 s42, s42, 1
    s_cselect_b32 s33, 8, 0
    s_sleep 4
    s_mov_b32 s50, s33
    s_atomic_cmpswap s[50:51], s[36:37], 0 glc
    s_waitcnt lgkmcnt(0)
    s_cmp_eq_u32 s50, 0
    s_cselect_b32 s58, s33, s50
    s_mov_b32 s50, s33
    s_atomic_cmpswap s[50:51], s[36:37], 128 glc
    s_waitcnt lgkmcnt(0)
    s_cmp_eq_u32 s50, 0
    s_cselect_b32 s59, s33, s50
    s_branch L_chk
L_full:
    s_add_u32 s32, s58, s2
    s_bitcmp1_b32 s32, 2
    s_cselect_b32 s33, s44, 0
    s_add_u32 s32, s59, s2
    s_bitcmp1_b32 s32, 2
    s_cselect_b32 s32, -1, 0
    s_andn2_b32 s32, s32, s44
    s_or_b32 s33, s33, s32
    s_bitset1_b32 s33, 31
    v_mov_b32 v2, s33
    ds_write_b32 v1, v2
    s_waitcnt lgkmcnt(0)
L_end:
    s_endpgm
L_worker:
    s_mov_b32 s14, 50331648
    s_mov_b32 s15, 0x20000
    s_mov_b32 s22, 18432
    s_mov_b32 s23, s15
    s_movk_i32 s26, 192
    s_mov_b32 s27, s15
    s_mul_i32 s32, s3, 3072
    s_add_u32 s34, s55, s32
    s_lshl_b32 s31, s3, 13
    s_add_u32 s33, s3, 0
    s_lshr_b32 s40, s33, 3
    s_mul_i32 s40, s40, 6266880
    s_mul_i32 s32, s33, 3072
    s_add_u32 s40, s40, s32
    s_xor_b32 s33, s33, s39
    s_bitcmp1_b32 s33, 0
    s_cselect_b32 s33, 24576, 0
    s_add_u32 s40, s40, s55
    s_add_u32 s40, s40, s33
    s_add_u32 s33, s3, 5
    s_lshr_b32 s41, s33, 3
    s_mul_i32 s41, s41, 6266880
    s_mul_i32 s32, s33, 3072
    s_add_u32 s41, s41, s32
    s_xor_b32 s33, s33, s39
    s_bitcmp1_b32 s33, 0
    s_cselect_b32 s33, 24576, 0
    s_add_u32 s41, s41, s55
    s_add_u32 s41, s41, s33
    v_lshlrev_b32 v5, 4, v0
    s_movk_i32 s32, 171
    v_mul_u32_u24 v153, s32, v0
    v_mov_b32 v154, 10944
    v_bfe_u32 v153, v153, 12, 2
    v_xor_b32 v153, v153, v0
    v_lshlrev_b32 v1, 4, v153
    v_mad_u32_u24 v153, v0, s32, v154
    v_mov_b32 v154, 21888
    v_bfe_u32 v153, v153, 12, 2
    v_xor_b32 v153, v153, v0
    v_lshlrev_b32 v2, 4, v153
    v_mad_u32_u24 v153, v0, s32, v154
    v_bfe_u32 v153, v153, 12, 2
    v_xor_b32 v153, v153, v0
    v_lshlrev_b32 v3, 4, v153
    s_mul_i32 s32, s3, 5120
    s_add_u32 m0, s32, 40960
    s_cmp_ge_u32 s3, 4
    s_waitcnt lgkmcnt(0)
    s_cbranch_scc1 L_x0
    buffer_load_dwordx4 v5, s[20:23], s32 offen offset:0 lds
    buffer_load_dwordx4 v5, s[20:23], s32 offen offset:1024 lds
    buffer_load_dwordx4 v5, s[20:23], s32 offen offset:2048 lds
    s_cmp_eq_u32 s3, 3
    s_cbranch_scc1 L_dw
    buffer_load_dwordx4 v5, s[20:23], s32 offen offset:3072 lds
    s_add_u32 m0, m0, 4096
    s_add_u32 s32, s32, 4096
    buffer_load_dwordx4 v5, s[20:23], s32 offen lds
    s_branch L_x0
L_dw:
    s_add_u32 m0, m0, 3072
    s_nop 0
    buffer_load_dwordx4 v5, s[24:27], 0 offen lds
L_x0:
    s_barrier
    s_mov_b32 m0, s31
    s_mov_b32 s30, 0xffff0000
    buffer_load_dwordx4 v1, s[12:15], s40 offen offset:0 nt lds
    buffer_load_dwordx4 v2, s[12:15], s40 offen offset:1024 nt lds
    buffer_load_dwordx4 v3, s[12:15], s40 offen offset:2048 nt lds
    s_mov_b32 s18, s14
    s_mov_b32 s19, s15
    v_and_b32 v152, 48, v0
    v_and_b32 v153, 15, v0
    v_mul_u32_u24 v4, 192, v153
    v_add_u32 v4, v4, v152
    v_lshlrev_b32 v153, 3, v0
    v_and_b32 v153, 48, v153
    v_xor_b32 v4, v4, v153
    v_add_u32 v4, s31, v4
    v_add_u32 v5, s31, v5
    v_bfe_u32 v153, v0, 2, 2
    v_lshrrev_b32 v154, 1, v152
    v_add_u32 v153, v153, v154
    v_mul_u32_u24 v153, 192, v153
    v_and_b32 v154, 3, v0
    v_lshl_add_u32 v153, v154, 4, v153
    v_add_u32 v7, 40960, v153
    v_add_u32 v152, 59392, v152
    s_add_u32 s32, s55, s12
    s_add_u32 s43, s32, 1536
    s_add_u32 s32, s32, 24576
    s_bitcmp1_b32 s32, 21
    s_cselect_b32 s35, -1, 0
    s_xor_b32 s35, s35, 170
    v_mov_b32 v6, 1
    s_mov_b32 s42, 2
    s_add_u32 m0, s31, 4096
    s_waitcnt vmcnt(3)
    s_barrier
    buffer_load_dwordx4 v1, s[12:15], s41 offen offset:0 nt lds
    buffer_load_dwordx4 v2, s[12:15], s41 offen offset:1024 nt lds
    buffer_load_dwordx4 v3, s[12:15], s41 offen offset:2048 nt lds
    ds_read_b128 v[104:107], v152 offset:0
    ds_read_b128 v[108:111], v152 offset:64
    ds_read_b128 v[112:115], v152 offset:128
    ds_read_b64_tr_b16 v[8:9], v7 offset:0
    ds_read_b64_tr_b16 v[10:11], v7 offset:768
    ds_read_b64_tr_b16 v[20:21], v7 offset:8
    ds_read_b64_tr_b16 v[22:23], v7 offset:776
    ds_read_b64_tr_b16 v[32:33], v7 offset:64
    ds_read_b64_tr_b16 v[34:35], v7 offset:832
    ds_read_b64_tr_b16 v[44:45], v7 offset:72
    ds_read_b64_tr_b16 v[46:47], v7 offset:840
    ds_read_b64_tr_b16 v[56:57], v7 offset:128
    ds_read_b64_tr_b16 v[58:59], v7 offset:896
    ds_read_b64_tr_b16 v[68:69], v7 offset:136
    ds_read_b64_tr_b16 v[70:71], v7 offset:904
    s_waitcnt lgkmcnt(12)
    v_lshlrev_b32 v80, 16, v104
    v_and_b32 v81, s30, v104
    v_lshlrev_b32 v82, 16, v105
    v_and_b32 v83, s30, v105
    v_lshlrev_b32 v84, 16, v106
    v_and_b32 v85, s30, v106
    v_lshlrev_b32 v86, 16, v107
    v_and_b32 v87, s30, v107
    v_lshlrev_b32 v88, 16, v108
    v_and_b32 v89, s30, v108
    v_lshlrev_b32 v90, 16, v109
    v_and_b32 v91, s30, v109
    v_lshlrev_b32 v92, 16, v110
    v_and_b32 v93, s30, v110
    v_lshlrev_b32 v94, 16, v111
    v_and_b32 v95, s30, v111
    v_lshlrev_b32 v96, 16, v112
    v_and_b32 v97, s30, v112
    v_lshlrev_b32 v98, 16, v113
    v_and_b32 v99, s30, v113
    v_lshlrev_b32 v100, 16, v114
    v_and_b32 v101, s30, v114
    v_lshlrev_b32 v102, 16, v115
    v_and_b32 v103, s30, v115
    ds_read_b64_tr_b16 v[12:13], v7 offset:6144
    ds_read_b64_tr_b16 v[14:15], v7 offset:6912
    ds_read_b64_tr_b16 v[24:25], v7 offset:6152
    ds_read_b64_tr_b16 v[26:27], v7 offset:6920
    ds_read_b64_tr_b16 v[36:37], v7 offset:6208
    ds_read_b64_tr_b16 v[38:39], v7 offset:6976
    ds_read_b64_tr_b16 v[48:49], v7 offset:6216
    ds_read_b64_tr_b16 v[50:51], v7 offset:6984
    ds_read_b64_tr_b16 v[60:61], v7 offset:6272
    ds_read_b64_tr_b16 v[62:63], v7 offset:7040
    ds_read_b64_tr_b16 v[72:73], v7 offset:6280
    ds_read_b64_tr_b16 v[74:75], v7 offset:7048
    ds_read_b64_tr_b16 v[16:17], v7 offset:12288
    ds_read_b64_tr_b16 v[18:19], v7 offset:13056
    ds_read_b64_tr_b16 v[28:29], v7 offset:12296
    ds_read_b64_tr_b16 v[30:31], v7 offset:13064
    ds_read_b64_tr_b16 v[40:41], v7 offset:12352
    ds_read_b64_tr_b16 v[42:43], v7 offset:13120
    ds_read_b64_tr_b16 v[52:53], v7 offset:12360
    ds_read_b64_tr_b16 v[54:55], v7 offset:13128
    ds_read_b64_tr_b16 v[64:65], v7 offset:12416
    ds_read_b64_tr_b16 v[66:67], v7 offset:13184
    ds_read_b64_tr_b16 v[76:77], v7 offset:12424
    ds_read_b64_tr_b16 v[78:79], v7 offset:13192
    v_mov_b32 v7, 60416
    s_waitcnt vmcnt(3)
L_loop:
    ds_read_b128 v[128:131], v4 offset:0
    ds_read_b128 v[132:135], v4 offset:64
    ds_read_b128 v[136:139], v4 offset:128
    s_waitcnt lgkmcnt(2)
    v_lshlrev_b32 v152, 16, v128
    v_and_b32 v153, s30, v128
    v_lshlrev_b32 v154, 16, v129
    v_and_b32 v155, s30, v129
    v_lshlrev_b32 v156, 16, v130
    v_and_b32 v157, s30, v130
    v_lshlrev_b32 v158, 16, v131
    v_and_b32 v159, s30, v131
    v_pk_mul_f32 v[152:153], v[152:153], v[80:81]
    v_pk_mul_f32 v[154:155], v[154:155], v[82:83]
    v_pk_mul_f32 v[156:157], v[156:157], v[84:85]
    v_pk_mul_f32 v[158:159], v[158:159], v[86:87]
    v_cvt_pk_bf16_f32 v128, v152, v153
    v_cvt_pk_bf16_f32 v129, v154, v155
    v_cvt_pk_bf16_f32 v130, v156, v157
    v_cvt_pk_bf16_f32 v131, v158, v159
    s_waitcnt lgkmcnt(1)
    v_lshlrev_b32 v152, 16, v132
    v_mfma_f32_16x16x32_bf16 v[104:107], v[8:11], v[128:131], 0
    v_and_b32 v153, s30, v132
    v_lshlrev_b32 v154, 16, v133
    v_and_b32 v155, s30, v133
    v_mfma_f32_16x16x32_bf16 v[108:111], v[20:23], v[128:131], 0
    v_lshlrev_b32 v156, 16, v134
    v_and_b32 v157, s30, v134
    v_lshlrev_b32 v158, 16, v135
    v_mfma_f32_16x16x32_bf16 v[112:115], v[32:35], v[128:131], 0
    v_and_b32 v159, s30, v135
    v_pk_mul_f32 v[152:153], v[152:153], v[88:89]
    v_pk_mul_f32 v[154:155], v[154:155], v[90:91]
    v_mfma_f32_16x16x32_bf16 v[116:119], v[44:47], v[128:131], 0
    v_pk_mul_f32 v[156:157], v[156:157], v[92:93]
    v_pk_mul_f32 v[158:159], v[158:159], v[94:95]
    v_cvt_pk_bf16_f32 v132, v152, v153
    v_mfma_f32_16x16x32_bf16 v[120:123], v[56:59], v[128:131], 0
    v_cvt_pk_bf16_f32 v133, v154, v155
    v_cvt_pk_bf16_f32 v134, v156, v157
    v_cvt_pk_bf16_f32 v135, v158, v159
    v_mfma_f32_16x16x32_bf16 v[124:127], v[68:71], v[128:131], 0
    s_waitcnt lgkmcnt(0)
    v_lshlrev_b32 v152, 16, v136
    v_mfma_f32_16x16x32_bf16 v[104:107], v[12:15], v[132:135], v[104:107]
    v_and_b32 v153, s30, v136
    v_lshlrev_b32 v154, 16, v137
    v_and_b32 v155, s30, v137
    v_mfma_f32_16x16x32_bf16 v[108:111], v[24:27], v[132:135], v[108:111]
    v_lshlrev_b32 v156, 16, v138
    v_and_b32 v157, s30, v138
    v_lshlrev_b32 v158, 16, v139
    v_mfma_f32_16x16x32_bf16 v[112:115], v[36:39], v[132:135], v[112:115]
    v_and_b32 v159, s30, v139
    v_pk_mul_f32 v[152:153], v[152:153], v[96:97]
    v_pk_mul_f32 v[154:155], v[154:155], v[98:99]
    v_mfma_f32_16x16x32_bf16 v[116:119], v[48:51], v[132:135], v[116:119]
    v_pk_mul_f32 v[156:157], v[156:157], v[100:101]
    v_pk_mul_f32 v[158:159], v[158:159], v[102:103]
    v_cvt_pk_bf16_f32 v136, v152, v153
    v_mfma_f32_16x16x32_bf16 v[120:123], v[60:63], v[132:135], v[120:123]
    v_cvt_pk_bf16_f32 v137, v154, v155
    v_cvt_pk_bf16_f32 v138, v156, v157
    v_cvt_pk_bf16_f32 v139, v158, v159
    v_mfma_f32_16x16x32_bf16 v[124:127], v[72:75], v[132:135], v[124:127]
    s_nop 0
    v_mfma_f32_16x16x32_bf16 v[104:107], v[16:19], v[136:139], v[104:107]
    v_mfma_f32_16x16x32_bf16 v[108:111], v[28:31], v[136:139], v[108:111]
    v_mfma_f32_16x16x32_bf16 v[112:115], v[40:43], v[136:139], v[112:115]
    v_mfma_f32_16x16x32_bf16 v[116:119], v[52:55], v[136:139], v[116:119]
    v_mfma_f32_16x16x32_bf16 v[120:123], v[64:67], v[136:139], v[120:123]
    v_mfma_f32_16x16x32_bf16 v[124:127], v[76:79], v[136:139], v[124:127]
    s_nop 2
    v_cvt_pk_bf16_f32 v140, v104, v105
    v_cvt_pk_bf16_f32 v141, v106, v107
    v_cvt_pk_bf16_f32 v142, v108, v109
    v_cvt_pk_bf16_f32 v143, v110, v111
    ds_write_b128 v4, v[140:143] offset:0
    v_cvt_pk_bf16_f32 v144, v112, v113
    v_cvt_pk_bf16_f32 v145, v114, v115
    v_cvt_pk_bf16_f32 v146, v116, v117
    v_cvt_pk_bf16_f32 v147, v118, v119
    ds_write_b128 v4, v[144:147] offset:64
    v_cvt_pk_bf16_f32 v148, v120, v121
    v_cvt_pk_bf16_f32 v149, v122, v123
    v_cvt_pk_bf16_f32 v150, v124, v125
    v_cvt_pk_bf16_f32 v151, v126, v127
    ds_write_b128 v4, v[148:151] offset:128
    s_mov_b64 exec, 1
    ds_add_rtn_u32 v152, v7, v6 offset:4
    s_mov_b64 exec, -1
    ds_read_b128 v[128:131], v5 offset:0
    ds_read_b128 v[132:135], v5 offset:1024
    ds_read_b128 v[136:139], v5 offset:2048
    v_xor_b32 v4, 0x1000, v4
    v_xor_b32 v5, 0x1000, v5
    s_waitcnt vmcnt(5) lgkmcnt(2)
    buffer_store_dwordx4 v[128:131], v1, s[16:19], s40 offen offset:0 sc0 sc1
    s_waitcnt vmcnt(5) lgkmcnt(1)
    buffer_store_dwordx4 v[132:135], v2, s[16:19], s40 offen offset:1024 sc0 sc1
    s_waitcnt vmcnt(5) lgkmcnt(0)
    buffer_store_dwordx4 v[136:139], v3, s[16:19], s40 offen offset:2048 sc0 sc1
    s_mov_b32 s40, s41
    v_readfirstlane_b32 s44, v152
    s_cmp_gt_u32 s42, 2
    s_cbranch_scc1 L_known
L_poll:
    ds_read_b32 v154, v7
    s_waitcnt lgkmcnt(0)
    v_readfirstlane_b32 s32, v154
    s_cmp_eq_u32 s32, 0
    s_cbranch_scc1 L_poll
    s_xor_b32 s35, s35, s32
L_known:
    s_cmp_gt_u32 s44, 63
    s_cbranch_scc1 L_tail
    s_mov_b32 s46, s44
    s_and_b32 s32, s44, 7
    s_lshr_b32 s44, s44, 3
    s_mul_i32 s32, s32, 3072
    s_mul_i32 s41, s44, 6291456
    s_add_u32 s33, s43, s32
    s_lshr_b32 s33, s33, 13
    s_lshr_b32 s44, s35, s44
    s_xor_b32 s33, s33, s44
    s_add_u32 s41, s41, s32
    s_bitcmp1_b32 s33, 0
    s_cselect_b32 s33, 24576, 0
    s_add_u32 s41, s41, s55
    s_mov_b32 m0, s31
    s_add_u32 s41, s41, s33
    buffer_load_dwordx4 v1, s[12:15], s41 offen offset:0 nt lds
    buffer_load_dwordx4 v2, s[12:15], s41 offen offset:1024 nt lds
    buffer_load_dwordx4 v3, s[12:15], s41 offen offset:2048 nt lds
    s_xor_b32 s31, s31, 0x1000
    s_add_u32 s42, s42, 1
    s_waitcnt vmcnt(6)
    s_branch L_loop
L_tail:
    s_cmp_lt_u32 s42, 0x100
    s_cbranch_scc0 L_fin
    s_and_b32 s32, s44, 7
    s_bfe_u32 s44, s44, 0x20003
    s_add_u32 s44, s44, 0
    s_mul_i32 s32, s32, 3072
    s_mul_i32 s41, s44, 6291456
    s_add_u32 s33, s43, s32
    s_lshr_b32 s33, s33, 13
    s_lshr_b32 s44, s35, s44
    s_xor_b32 s33, s33, s44
    s_add_u32 s41, s41, s32
    s_bitcmp1_b32 s33, 0
    s_cselect_b32 s33, 24576, 0
    s_xor_b32 s32, s38, 1
    s_mul_i32 s32, s32, 49152
    s_add_u32 s41, s41, s32
    s_mov_b32 m0, s31
    s_add_u32 s41, s41, s33
    buffer_load_dwordx4 v1, s[12:15], s41 offen offset:0 nt lds
    buffer_load_dwordx4 v2, s[12:15], s41 offen offset:1024 nt lds
    s_xor_b32 s31, s31, 0x1000
    s_cmp_lt_u32 s42, 0x100
    s_cbranch_scc0 L_fin
    s_movk_i32 s42, 0x100
    s_waitcnt vmcnt(5)
    s_branch L_loop
L_fin:
    s_endpgm
.section .rodata,"a"
.p2align 6
.amdhsa_kernel standalone__depthwise_separable__vision_kernel
  .amdhsa_next_free_vgpr 160
  .amdhsa_next_free_sgpr 60
  .amdhsa_accum_offset 160
  .amdhsa_group_segment_fixed_size 0
  .amdhsa_kernarg_size 48
  .amdhsa_user_sgpr_count 2
  .amdhsa_user_sgpr_kernarg_segment_ptr 1
  .amdhsa_system_sgpr_workgroup_id_x 1
  .amdhsa_float_denorm_mode_32 3
  .amdhsa_float_denorm_mode_16_64 3
.end_amdhsa_kernel
```
